```python
import torch

def _softmax(x, axis=-1):
    return torch.softmax(x, dim=axis)
def _gelu(x):
    return torch.nn.functional.gelu(x, approximate="tanh")
def _silu(x):
    return torch.nn.functional.silu(x)
def _sigmoid(x):
    return torch.sigmoid(x)
def _layernorm(x, axis=-1, eps=1e-5):
    m = x.mean(dim=axis, keepdim=True)
    v = x.var(dim=axis, keepdim=True, unbiased=False)
    return (x - m) / torch.sqrt(v + eps)
def _scatter_add(tgt, idx, src, axis=0):
    return tgt.clone().index_add_(axis, idx, src)
def _segment_sum(src, seg, n):
    out = torch.zeros((n,) + src.shape[1:], dtype=src.dtype)
    return out.index_add_(0, seg, src)
def _pad(x, pw):
    flat = tuple(v for pair in reversed(pw) for v in pair)
    return torch.nn.functional.pad(x, flat)

kernel_name = 'standalone__glu_gated_reglu__decode'

def setup_inputs():

    _w = (lambda a: (lambda t: t.to(torch.bfloat16) if t.is_floating_point() else t)(torch.as_tensor(a)))
    B, S, D, F = 1, 1, 1024, 3584
    return {
        "x": _w((lambda *s: torch.randn(*s, dtype=torch.bfloat16) * 0.05)(B, S, D)),
        "W_gate": _w((lambda *s: torch.randn(*s, dtype=torch.bfloat16) * 0.05)(D, F) * (2.0 / D) ** 0.5),
        "W_up": _w((lambda *s: torch.randn(*s, dtype=torch.bfloat16) * 0.05)(D, F) * (2.0 / D) ** 0.5),
        "W_down": _w((lambda *s: torch.randn(*s, dtype=torch.bfloat16) * 0.05)(F, D) * (1.0 / F) ** 0.5),
    }

def reference(x, W_gate, W_up, W_down):
    gate = torch.einsum("bsd,df->bsf", x, W_gate)
    up = torch.einsum("bsd,df->bsf", x, W_up)
    gate = gate * (lambda x, dt: x.to(dt))(gate > 0, gate.dtype)
    h = gate * up
    return torch.einsum("bsf,fd->bsd", h, W_down)
```

```asm
; @launch grid=(256,1,1) block=(512,1,1) lds=4096
.amdgcn_target "amdgcn-amd-amdhsa--gfx950"
.text
.globl standalone__glu_gated_reglu__decode_kernel
.p2align 8
.type standalone__glu_gated_reglu__decode_kernel,@function
standalone__glu_gated_reglu__decode_kernel:
    s_load_dwordx8 s[4:11], s[0:1], 0
    v_lshrrev_b32 v1, 6, v0
    s_add_u32 s19, s2, 3
    s_and_b32 s19, s19, 7
    v_readfirstlane_b32 s18, v1
    v_and_b32 v0, 63, v0
    s_lshr_b32 s20, s2, 3
    s_cmp_ge_u32 s2, 256
    s_cbranch_scc1 L_end
    s_cmp_ge_u32 s18, 4
    s_cbranch_scc1 L_p2
    s_lshr_b32 s22, s20, 2
    s_lshl3_add_u32 s21, s19, s22
    s_add_u32 s22, s21, 4
    s_mul_i32 s22, s22, 37
    s_lshr_b32 s22, s22, 8
    s_add_u32 s28, s21, s22
    s_and_b32 s22, s20, 24
    s_lshl_b32 s23, s19, 5
    s_add_u32 s22, s22, s23
    s_sub_u32 s22, s22, 189
    s_min_u32 s22, s22, 55
    s_cmp_ge_u32 s19, 6
    s_cselect_b32 s28, s22, s28
    s_cselect_b32 s26, 1, 0
    s_cselect_b32 s22, 7, 3
    s_and_b32 s27, s20, s22
    s_lshl3_add_u32 s21, s18, s27
    s_lshl_b32 s21, s21, 5
    v_lshrrev_b32 v1, 4, v0
    v_and_b32 v2, 7, v0
    v_lshl_add_u32 v3, v1, 3, s21
    v_lshlrev_b32 v4, 1, v3
    v_mul_u32_u24 v3, 7168, v3
    s_lshl_b32 s22, s28, 7
    s_add_u32 s22, s22, 3584
    v_lshl_add_u32 v5, v2, 4, s22
    v_add_u32 v6, v3, v5
    v_mov_b32 v7, 0
    v_and_b32 v8, 8, v0
    v_cmp_eq_u32 vcc, 0, v8
    s_movk_i32 s36, 14336
    s_mov_b32 s37, 0
    s_waitcnt lgkmcnt(0)
    v_mov_b32 v8, s8
    v_mov_b32 v9, s9
    v_mov_b32 v10, s6
    v_mov_b32 v11, s7
    global_load_dwordx4 v[16:19], v4, s[4:5]
    v_cndmask_b32 v8, v8, v10, vcc
    v_cndmask_b32 v9, v9, v11, vcc
    v_lshl_add_u64 v[6:7], v[6:7], 0, v[8:9]
    global_load_dwordx4 v[32:35], v[6:7], off offset:-3584 nt
    global_load_dwordx4 v[36:39], v[6:7], off offset:3584 nt
    s_load_dwordx2 s[16:17], s[0:1], 48
    s_load_dwordx2 s[12:13], s[0:1], 32
    s_mov_b32 s38, 874496
    s_mov_b32 s39, 0
    v_lshl_add_u64 v[6:7], v[6:7], 0, s[36:37]
    global_load_dwordx4 v[40:43], v[6:7], off offset:-3584 nt
    global_load_dwordx4 v[44:47], v[6:7], off offset:3584 nt
    v_lshl_add_u64 v[6:7], v[6:7], 0, s[36:37]
    global_load_dwordx4 v[48:51], v[6:7], off offset:-3584 nt
    global_load_dwordx4 v[52:55], v[6:7], off offset:3584 nt
    v_lshl_add_u64 v[6:7], v[6:7], 0, s[36:37]
    global_load_dwordx4 v[56:59], v[6:7], off offset:-3584 nt
    global_load_dwordx4 v[60:63], v[6:7], off offset:3584 nt
    v_lshl_add_u64 v[6:7], v[6:7], 0, s[38:39]
    s_cmp_lg_u32 s26, 0
    s_cbranch_scc1 L_p1_issued
    global_load_dwordx4 v[20:23], v4, s[4:5] offset:256
    global_load_dwordx4 v[64:67], v[6:7], off offset:-3584 nt
    global_load_dwordx4 v[68:71], v[6:7], off offset:3584 nt
    v_lshl_add_u64 v[6:7], v[6:7], 0, s[36:37]
    global_load_dwordx4 v[72:75], v[6:7], off offset:-3584 nt
    global_load_dwordx4 v[76:79], v[6:7], off offset:3584 nt
    v_lshl_add_u64 v[6:7], v[6:7], 0, s[36:37]
    global_load_dwordx4 v[80:83], v[6:7], off offset:-3584 nt
    global_load_dwordx4 v[84:87], v[6:7], off offset:3584 nt
    v_lshl_add_u64 v[6:7], v[6:7], 0, s[36:37]
    global_load_dwordx4 v[88:91], v[6:7], off offset:-3584 nt
    global_load_dwordx4 v[92:95], v[6:7], off offset:3584 nt
L_p1_issued:
    s_waitcnt lgkmcnt(0)
    s_load_dwordx2 s[24:25], s[16:17], 0
    s_mov_b32 s41, 0
    v_and_b32 v1, 15, v0
    v_and_b32 v2, 1, v0
    v_cmp_eq_u32 vcc, 0, v2
    v_mov_b32 v3, 0x01000c0c
    v_mov_b32 v4, 0x0c0c0100
    v_mov_b32 v5, 0x03020c0c
    v_mov_b32 v6, 0x0c0c0302
    v_cndmask_b32 v3, v3, v4, vcc
    v_cndmask_b32 v5, v5, v6, vcc
    v_lshrrev_b32 v1, 1, v1
    v_mov_b32 v4, 0x0c0c0c0c
    v_cmp_eq_u32 vcc, 0, v1
    v_mov_b32 v28, 0
    s_nop 0
    v_cndmask_b32 v8, v4, v3, vcc
    v_cndmask_b32 v12, v4, v5, vcc
    v_cmp_eq_u32 vcc, 1, v1
    v_mov_b32 v29, 0
    s_nop 0
    v_cndmask_b32 v9, v4, v3, vcc
    v_cndmask_b32 v13, v4, v5, vcc
    v_cmp_eq_u32 vcc, 2, v1
    v_mov_b32 v30, 0
    s_nop 0
    v_cndmask_b32 v10, v4, v3, vcc
    v_cndmask_b32 v14, v4, v5, vcc
    v_cmp_eq_u32 vcc, 3, v1
    v_mov_b32 v31, 0
    s_nop 0
    v_cndmask_b32 v11, v4, v3, vcc
    v_cndmask_b32 v15, v4, v5, vcc
    v_and_b32 v1, 7, v0
    v_lshlrev_b32 v1, 5, v1
    v_and_b32 v2, 8, v0
    v_lshl_add_u32 v1, v2, 5, v1
    v_and_b32 v2, 16, v0
    s_lshl_b32 s21, s18, 9
    v_add3_u32 v1, v1, v2, s21
    s_lshl_b32 s21, s28, 12
    s_lshl_b32 s22, s27, 9
    s_add_u32 s21, s21, s22
    s_add_u32 s21, s21, 2113536
    s_cmp_eq_u32 s18, 3
    s_cselect_b32 s22, 2097152, 0
    s_sub_u32 s21, s21, s22
    v_and_b32 v2, 31, v0
    v_lshl_add_u32 v2, v2, 4, s21
    v_lshlrev_b32 v3, 3, v0
    v_lshrrev_b32 v96, 2, v0
    v_and_b32 v96, 8, v96
    s_movk_i32 s40, 0xff
    s_waitcnt lgkmcnt(0)
    s_add_u32 s24, s24, 2654435769
    s_add_u32 s25, s25, 2135587861
    v_lshrrev_b32 v96, v96, s24
    v_lshrrev_b32 v97, 16, v96
    s_cmp_lg_u32 s26, 0
    s_cbranch_scc1 L_p1_half
    s_waitcnt vmcnt(17)
    v_perm_b32 v24, v16, v16, v8
    v_perm_b32 v25, v16, v16, v9
    v_perm_b32 v26, v16, v16, v10
    v_perm_b32 v27, v16, v16, v11
    s_waitcnt vmcnt(16)
    s_nop 0
    v_mfma_f32_16x16x32_bf16 v[28:31], v[24:27], v[32:35], v[28:31]
    v_perm_b32 v4, v16, v16, v12
    v_perm_b32 v5, v16, v16, v13
    v_perm_b32 v6, v16, v16, v14
    v_perm_b32 v7, v16, v16, v15
    s_waitcnt vmcnt(15)
    s_nop 0
    v_mfma_f32_16x16x32_bf16 v[28:31], v[4:7], v[36:39], v[28:31]
    v_perm_b32 v24, v17, v17, v8
    v_perm_b32 v25, v17, v17, v9
    v_perm_b32 v26, v17, v17, v10
    v_perm_b32 v27, v17, v17, v11
    s_waitcnt vmcnt(14)
    s_nop 0
    v_mfma_f32_16x16x32_bf16 v[28:31], v[24:27], v[40:43], v[28:31]
    v_perm_b32 v4, v17, v17, v12
    v_perm_b32 v5, v17, v17, v13
    v_perm_b32 v6, v17, v17, v14
    v_perm_b32 v7, v17, v17, v15
    s_waitcnt vmcnt(13)
    s_nop 0
    v_mfma_f32_16x16x32_bf16 v[28:31], v[4:7], v[44:47], v[28:31]
    v_perm_b32 v24, v18, v18, v8
    v_perm_b32 v25, v18, v18, v9
    v_perm_b32 v26, v18, v18, v10
    v_perm_b32 v27, v18, v18, v11
    s_waitcnt vmcnt(12)
    s_nop 0
    v_mfma_f32_16x16x32_bf16 v[28:31], v[24:27], v[48:51], v[28:31]
    v_perm_b32 v4, v18, v18, v12
    v_perm_b32 v5, v18, v18, v13
    v_perm_b32 v6, v18, v18, v14
    v_perm_b32 v7, v18, v18, v15
    s_waitcnt vmcnt(11)
    s_nop 0
    v_mfma_f32_16x16x32_bf16 v[28:31], v[4:7], v[52:55], v[28:31]
    v_perm_b32 v24, v19, v19, v8
    v_perm_b32 v25, v19, v19, v9
    v_perm_b32 v26, v19, v19, v10
    v_perm_b32 v27, v19, v19, v11
    s_waitcnt vmcnt(10)
    s_nop 0
    v_mfma_f32_16x16x32_bf16 v[28:31], v[24:27], v[56:59], v[28:31]
    v_perm_b32 v4, v19, v19, v12
    v_perm_b32 v5, v19, v19, v13
    v_perm_b32 v6, v19, v19, v14
    v_perm_b32 v7, v19, v19, v15
    s_waitcnt vmcnt(9)
    s_nop 0
    v_mfma_f32_16x16x32_bf16 v[28:31], v[4:7], v[60:63], v[28:31]
    s_barrier
    s_waitcnt vmcnt(8)
    v_perm_b32 v24, v20, v20, v8
    v_perm_b32 v25, v20, v20, v9
    v_perm_b32 v26, v20, v20, v10
    v_perm_b32 v27, v20, v20, v11
    s_waitcnt vmcnt(7)
    s_nop 0
    v_mfma_f32_16x16x32_bf16 v[28:31], v[24:27], v[64:67], v[28:31]
    v_perm_b32 v4, v20, v20, v12
    v_perm_b32 v5, v20, v20, v13
    v_perm_b32 v6, v20, v20, v14
    v_perm_b32 v7, v20, v20, v15
    s_waitcnt vmcnt(6)
    s_nop 0
    v_mfma_f32_16x16x32_bf16 v[28:31], v[4:7], v[68:71], v[28:31]
    v_perm_b32 v24, v21, v21, v8
    v_perm_b32 v25, v21, v21, v9
    v_perm_b32 v26, v21, v21, v10
    v_perm_b32 v27, v21, v21, v11
    s_waitcnt vmcnt(5)
    s_nop 0
    v_mfma_f32_16x16x32_bf16 v[28:31], v[24:27], v[72:75], v[28:31]
    v_perm_b32 v4, v21, v21, v12
    v_perm_b32 v5, v21, v21, v13
    v_perm_b32 v6, v21, v21, v14
    v_perm_b32 v7, v21, v21, v15
    s_waitcnt vmcnt(4)
    s_nop 0
    v_mfma_f32_16x16x32_bf16 v[28:31], v[4:7], v[76:79], v[28:31]
    v_perm_b32 v24, v22, v22, v8
    v_perm_b32 v25, v22, v22, v9
    v_perm_b32 v26, v22, v22, v10
    v_perm_b32 v27, v22, v22, v11
    s_waitcnt vmcnt(3)
    s_nop 0
    v_mfma_f32_16x16x32_bf16 v[28:31], v[24:27], v[80:83], v[28:31]
    v_perm_b32 v4, v22, v22, v12
    v_perm_b32 v5, v22, v22, v13
    v_perm_b32 v6, v22, v22, v14
    v_perm_b32 v7, v22, v22, v15
    s_waitcnt vmcnt(2)
    s_nop 0
    v_mfma_f32_16x16x32_bf16 v[28:31], v[4:7], v[84:87], v[28:31]
    v_perm_b32 v24, v23, v23, v8
    v_perm_b32 v25, v23, v23, v9
    v_perm_b32 v26, v23, v23, v10
    v_perm_b32 v27, v23, v23, v11
    s_waitcnt vmcnt(1)
    s_nop 0
    v_mfma_f32_16x16x32_bf16 v[28:31], v[24:27], v[88:91], v[28:31]
    v_perm_b32 v4, v23, v23, v12
    v_perm_b32 v5, v23, v23, v13
    v_perm_b32 v6, v23, v23, v14
    v_perm_b32 v7, v23, v23, v15
    s_waitcnt vmcnt(0)
    s_nop 0
    v_mfma_f32_16x16x32_bf16 v[28:31], v[4:7], v[92:95], v[28:31]
L_p1_acc:
    s_mov_b32 exec_hi, 0
    s_nop 6
    ds_write_b128 v1, v[28:31]
    s_mov_b32 exec_hi, -1
    s_waitcnt lgkmcnt(0)
    s_barrier
    s_cmp_gt_u32 s18, 1
    s_cbranch_scc0 L_np
    ds_read2st64_b64 v[4:7], v3 offset0:0 offset1:1
    ds_read2st64_b64 v[8:11], v3 offset0:2 offset1:3
    s_cmp_eq_u32 s18, 3
    s_waitcnt lgkmcnt(1)
    v_add_f32 v4, v4, v6
    v_add_f32 v5, v5, v7
    s_waitcnt lgkmcnt(0)
    v_add_f32 v8, v8, v10
    v_add_f32 v9, v9, v11
    v_add_f32 v4, v4, v8
    v_add_f32 v5, v5, v9
    v_add_u32 v4, 0x80, v4
    v_add_u32 v5, 0x80, v5
    v_bfi_b32 v16, s40, v96, v4
    v_bfi_b32 v18, s40, v97, v5
    s_nop 0
    v_permlane32_swap_b32 v16, v17
    v_permlane32_swap_b32 v18, v19
    s_mov_b32 exec_hi, 0
    s_cbranch_scc1 L_pubA
    global_store_dwordx4 v2, v[16:19], s[16:17] sc1
    s_mov_b32 exec_hi, -1
    s_branch L_fin
L_pubA:
    global_store_dwordx4 v2, v[16:19], s[16:17]
    s_mov_b32 exec_hi, -1
    s_branch L_fin
L_np:
    s_endpgm
L_p1_half:
    s_waitcnt vmcnt(8)
    v_perm_b32 v24, v16, v16, v8
    v_perm_b32 v25, v16, v16, v9
    v_perm_b32 v26, v16, v16, v10
    v_perm_b32 v27, v16, v16, v11
    s_waitcnt vmcnt(7)
    s_nop 0
    v_mfma_f32_16x16x32_bf16 v[28:31], v[24:27], v[32:35], v[28:31]
    v_perm_b32 v4, v16, v16, v12
    v_perm_b32 v5, v16, v16, v13
    v_perm_b32 v6, v16, v16, v14
    v_perm_b32 v7, v16, v16, v15
    s_waitcnt vmcnt(6)
    s_nop 0
    v_mfma_f32_16x16x32_bf16 v[28:31], v[4:7], v[36:39], v[28:31]
    v_perm_b32 v24, v17, v17, v8
    v_perm_b32 v25, v17, v17, v9
    v_perm_b32 v26, v17, v17, v10
    v_perm_b32 v27, v17, v17, v11
    s_waitcnt vmcnt(5)
    s_nop 0
    v_mfma_f32_16x16x32_bf16 v[28:31], v[24:27], v[40:43], v[28:31]
    v_perm_b32 v4, v17, v17, v12
    v_perm_b32 v5, v17, v17, v13
    v_perm_b32 v6, v17, v17, v14
    v_perm_b32 v7, v17, v17, v15
    s_waitcnt vmcnt(4)
    s_nop 0
    v_mfma_f32_16x16x32_bf16 v[28:31], v[4:7], v[44:47], v[28:31]
    v_perm_b32 v24, v18, v18, v8
    v_perm_b32 v25, v18, v18, v9
    v_perm_b32 v26, v18, v18, v10
    v_perm_b32 v27, v18, v18, v11
    s_waitcnt vmcnt(3)
    s_nop 0
    v_mfma_f32_16x16x32_bf16 v[28:31], v[24:27], v[48:51], v[28:31]
    v_perm_b32 v4, v18, v18, v12
    v_perm_b32 v5, v18, v18, v13
    v_perm_b32 v6, v18, v18, v14
    v_perm_b32 v7, v18, v18, v15
    s_waitcnt vmcnt(2)
    s_nop 0
    v_mfma_f32_16x16x32_bf16 v[28:31], v[4:7], v[52:55], v[28:31]
    v_perm_b32 v24, v19, v19, v8
    v_perm_b32 v25, v19, v19, v9
    v_perm_b32 v26, v19, v19, v10
    v_perm_b32 v27, v19, v19, v11
    s_waitcnt vmcnt(1)
    s_nop 0
    v_mfma_f32_16x16x32_bf16 v[28:31], v[24:27], v[56:59], v[28:31]
    v_perm_b32 v4, v19, v19, v12
    v_perm_b32 v5, v19, v19, v13
    v_perm_b32 v6, v19, v19, v14
    v_perm_b32 v7, v19, v19, v15
    s_waitcnt vmcnt(0)
    s_nop 0
    v_mfma_f32_16x16x32_bf16 v[28:31], v[4:7], v[60:63], v[28:31]
    s_barrier
    s_branch L_p1_acc
L_fin:
    s_barrier
    s_add_u32 s23, s19, 1
    s_cmp_ge_u32 s19, 4
    s_addc_u32 s23, s23, 0
    s_cmp_eq_u32 s19, 0
    s_cselect_b32 s23, 0, s23
    s_lshl_b32 s22, s19, 2
    s_sub_u32 s22, s22, 23
    s_cmp_eq_u32 s26, 1
    s_cselect_b32 s23, s22, s23
    s_lshl_b32 s21, s19, 14
    s_add_u32 s21, s21, 524288
    s_lshl_b32 s22, s20, 9
    s_add_u32 s22, s22, s21
    v_and_b32 v1, 31, v0
    v_lshl_add_u32 v1, v1, 4, s22
    s_lshl_b32 s22, s20, 4
    s_add_u32 s21, s21, s22
    v_and_b32 v2, 15, v0
    v_lshlrev_b32 v2, 10, v2
    v_bfe_u32 v4, v0, 4, 1
    v_lshlrev_b32 v4, 9, v4
    v_add3_u32 v2, v2, v4, s21
    s_lshl_b32 s21, s23, 8
    s_lshl_b32 s22, s20, 3
    s_add_u32 s21, s21, s22
    v_lshrrev_b32 v20, 4, v0
    v_lshl_add_u32 v20, v20, 1, s21
    s_mov_b32 s42, 0x0c040c00
    s_mov_b32 s43, 0x040c000c
    s_movk_i32 s44, 0xff00
    s_cmp_eq_u32 s18, 3
    s_cbranch_scc1 L_finB
    global_load_dwordx4 v[32:35], v1, s[16:17] sc1
    s_barrier
    ds_read2st64_b64 v[4:7], v3 offset0:4 offset1:5
    ds_read2st64_b64 v[8:11], v3 offset0:6 offset1:7
    s_waitcnt lgkmcnt(1)
    v_add_f32 v4, v4, v6
    v_add_f32 v5, v5, v7
    s_waitcnt lgkmcnt(0)
    v_add_f32 v8, v8, v10
    v_add_f32 v9, v9, v11
    v_add_f32 v12, v4, v8
    v_add_f32 v14, v5, v9
    v_add_u32 v12, 0x80, v12
    v_add_u32 v14, 0x80, v14
    v_bfi_b32 v12, s40, v96, v12
    v_bfi_b32 v13, s40, v97, v14
    s_nop 0
    v_permlane32_swap_b32 v12, v14
    v_permlane32_swap_b32 v13, v15
    s_mov_b32 exec_hi, 0
    global_store_dwordx4 v2, v[12:15], s[16:17]
    s_mov_b32 exec_hi, -1
    global_load_dwordx4 v[32:35], v1, s[16:17] sc1
    global_load_dwordx4 v[36:39], v1, s[16:17] sc1
L_pollF:
    s_waitcnt vmcnt(1)
    v_perm_b32 v5, v33, v32, s42
    v_perm_b32 v6, v35, v34, s43
    v_and_b32 v7, s44, v32
    v_and_b32 v8, s44, v33
    v_and_b32 v9, s44, v34
    v_and_b32 v10, s44, v35
    v_bitop3_b32 v5, v5, v6, s24 bitop3:0x96
    v_permlane32_swap_b32 v7, v9
    v_cmp_ne_u32 vcc, 0, v5
    v_permlane32_swap_b32 v8, v10
    s_add_u32 s41, s41, 1
    s_cbranch_vccz L_okF
    global_load_dwordx4 v[32:35], v1, s[16:17] sc1
    s_waitcnt vmcnt(1)
    v_perm_b32 v5, v37, v36, s42
    v_perm_b32 v6, v39, v38, s43
    v_and_b32 v7, s44, v36
    v_and_b32 v8, s44, v37
    v_and_b32 v9, s44, v38
    v_and_b32 v10, s44, v39
    v_bitop3_b32 v5, v5, v6, s24 bitop3:0x96
    v_permlane32_swap_b32 v7, v9
    v_cmp_ne_u32 vcc, 0, v5
    v_permlane32_swap_b32 v8, v10
    s_add_u32 s41, s41, 1
    s_cbranch_vccz L_okF
    global_load_dwordx4 v[36:39], v1, s[16:17] sc1
    s_cmp_lt_u32 s41, 128
    s_cbranch_scc1 L_pollF
    v_xor_b32 v1, 1048576, v1
    s_cmp_lt_u32 s41, 200000
    s_cbranch_scc1 L_pollF
L_okF:
    s_nop 0
    v_permlane16_swap_b32 v7, v8
    s_nop 0
    v_add_f32 v7, v7, v8
    s_nop 1
    v_add_f32_dpp v7, v7, v7 quad_perm:[1,0,3,2] row_mask:0xf bank_mask:0xf
    s_nop 1
    v_add_f32_dpp v7, v7, v7 quad_perm:[2,3,0,1] row_mask:0xf bank_mask:0xf
    s_nop 1
    v_add_f32_dpp v7, v7, v7 row_ror:4 row_mask:0xf bank_mask:0xf
    s_nop 1
    v_add_f32_dpp v7, v7, v7 row_ror:8 row_mask:0xf bank_mask:0xf
    s_mov_b32 exec_lo, 0x00010001
    s_mov_b32 exec_hi, 0x00010001
    v_cvt_pk_bf16_f32 v7, v7, v7
    global_store_short v20, v7, s[12:13]
    s_cmp_lg_u32 s2, 0
    s_cbranch_scc1 L_fin_done
    s_mov_b64 exec, 1
    v_mov_b32 v1, 0
    v_mov_b32 v2, s24
    v_mov_b32 v3, s25
    global_store_dwordx2 v1, v[2:3], s[16:17]
L_fin_done:
    s_endpgm
L_finB:
    s_getreg_b32 s22, hwreg(HW_REG_XCC_ID, 0, 4)
    s_lshl_b32 s21, s19, 8
    s_add_u32 s21, s21, 786432
    v_and_b32 v4, 31, v0
    v_lshl_add_u32 v4, v4, 3, s21
    global_load_dwordx2 v[6:7], v4, s[16:17] sc1
    s_add_u32 s22, s22, s25
    s_waitcnt vmcnt(0)
    v_xor_b32 v6, s24, v6
    v_bitop3_b32 v6, v6, v7, s22 bitop3:0xf6
    v_cmp_ne_u32 vcc, 0, v6
    s_cbranch_vccz L_finB_done
    v_add_u32 v2, 1048576, v2
    s_barrier
    ds_read2st64_b64 v[4:7], v3 offset0:4 offset1:5
    ds_read2st64_b64 v[8:11], v3 offset0:6 offset1:7
    s_waitcnt lgkmcnt(1)
    v_add_f32 v4, v4, v6
    v_add_f32 v5, v5, v7
    s_waitcnt lgkmcnt(0)
    v_add_f32 v8, v8, v10
    v_add_f32 v9, v9, v11
    v_add_f32 v12, v4, v8
    v_add_f32 v14, v5, v9
    v_add_u32 v12, 0x80, v12
    v_add_u32 v14, 0x80, v14
    v_bfi_b32 v12, s40, v96, v12
    v_bfi_b32 v13, s40, v97, v14
    s_nop 0
    v_permlane32_swap_b32 v12, v14
    v_permlane32_swap_b32 v13, v15
    s_mov_b32 exec_hi, 0
    global_store_dwordx4 v2, v[12:15], s[16:17] sc1
L_finB_done:
    s_endpgm
L_p2:
    s_load_dwordx2 s[16:17], s[0:1], 48
    s_sub_u32 s30, s18, 4
    s_mov_b32 s41, 0
    s_mul_i32 s21, s20, 112
    s_mul_i32 s22, s30, 28
    s_add_u32 s21, s21, s22
    s_cmp_ge_u32 s19, 6
    s_cselect_b32 s26, 1, 0
    s_add_u32 s23, s19, 1
    s_cmp_ge_u32 s19, 4
    s_addc_u32 s23, s23, 0
    s_cmp_eq_u32 s19, 0
    s_cselect_b32 s23, 0, s23
    s_lshl_b32 s22, s19, 2
    s_sub_u32 s22, s22, 23
    s_cmp_eq_u32 s26, 1
    s_cselect_b32 s23, s22, s23
    v_lshrrev_b32 v1, 4, v0
    v_and_b32 v2, 15, v0
    s_lshl_b32 s22, s23, 8
    v_lshl_add_u32 v5, v2, 4, s22
    v_lshl_add_u32 v4, v1, 1, s21
    v_lshl_add_u32 v3, v4, 11, v5
    v_and_b32 v6, 1, v1
    v_lshrrev_b32 v7, 1, v1
    v_lshl_add_u32 v7, v6, 1, v7
    s_add_u32 s22, s21, 24
    v_add_u32 v7, s22, v7
    v_lshl_add_u32 v14, v7, 11, v5
    s_movk_i32 s38, 16384
    s_mov_b32 s39, 32768
    s_waitcnt lgkmcnt(0)
    s_load_dwordx2 s[24:25], s[16:17], 0
    s_mov_b32 s32, s10
    s_and_b32 s33, s11, 0xffff
    s_mov_b32 s34, 7340032
    s_mov_b32 s35, 0x20000
    v_bfe_u32 v5, v2, 2, 1
    v_lshrrev_b32 v12, 3, v2
    v_lshl_add_u32 v5, v5, 1, v12
    v_and_b32 v12, 1, v2
    v_lshl_add_u32 v5, v12, 3, v5
    v_and_b32 v12, 2, v2
    v_cmp_eq_u32 vcc, 0, v12
    v_mov_b32 v12, 0xffff0000
    v_mov_b32 v7, 0x0000ffff
    v_cndmask_b32 v12, v12, v7, vcc
    v_cmp_eq_u32 vcc, 0, v5
    v_mov_b32 v24, 0
    v_mov_b32 v28, 0
    v_cndmask_b32 v8, 0, v12, vcc
    v_cmp_eq_u32 vcc, 1, v5
    v_mov_b32 v25, 0
    v_mov_b32 v29, 0
    v_cndmask_b32 v9, 0, v12, vcc
    v_cmp_eq_u32 vcc, 2, v5
    v_mov_b32 v26, 0
    v_mov_b32 v30, 0
    v_cndmask_b32 v10, 0, v12, vcc
    v_cmp_eq_u32 vcc, 3, v5
    v_mov_b32 v27, 0
    v_mov_b32 v31, 0
    v_cndmask_b32 v11, 0, v12, vcc
    v_bfe_u32 v5, v0, 2, 2
    v_cmp_eq_u32 vcc, 3, v5
    v_lshlrev_b32 v5, 3, v5
    s_nop 0
    v_cndmask_b32 v6, v1, v6, vcc
    v_lshl_add_u32 v4, v6, 1, v5
    v_add_u32 v4, s21, v4
    v_lshrrev_b32 v5, 6, v4
    v_and_b32 v4, 63, v4
    v_lshlrev_b32 v4, 3, v4
    v_lshl_add_u32 v4, v5, 12, v4
    v_and_b32 v6, 3, v0
    v_lshl_add_u32 v4, v6, 9, v4
    s_lshl_b32 s22, s19, 31
    s_and_b32 s22, s22, 0x1fffff
    s_add_u32 s22, s22, 2113536
    v_add_u32 v13, s22, v4
    v_and_b32 v6, 7, v5
    v_cmp_eq_u32 s[44:45], 3, v6
    v_cmp_eq_u32 vcc, 55, v5
    s_or_b64 s[44:45], s[44:45], vcc
    s_lshl_b32 s29, s19, 3
    s_add_u32 s22, s29, 4
    s_mul_i32 s22, s22, 37
    s_lshr_b32 s22, s22, 8
    s_add_u32 s22, s22, s29
    s_add_u32 s23, s29, 11
    s_mul_i32 s23, s23, 37
    s_lshr_b32 s23, s23, 8
    s_add_u32 s23, s23, s29
    s_add_u32 s23, s23, 7
    s_sub_u32 s23, s23, s22
    s_lshl_b32 s21, s19, 5
    s_and_b32 s21, s21, 32
    s_cmp_eq_u32 s26, 1
    s_cselect_b32 s22, s21, s22
    s_cselect_b32 s23, 31, s23
    s_cselect_b64 s[46:47], 0, -1
    s_xor_b64 s[46:47], s[46:47], s[44:45]
    v_subrev_u32 v5, s22, v5
    v_cmp_ge_u32 vcc, s23, v5
    s_and_b64 vcc, vcc, s[46:47]
    v_add_u32 v4, 16384, v4
    v_lshlrev_b32 v15, 3, v0
    s_lshl_b32 s21, s30, 9
    v_cndmask_b32 v12, v13, v4, vcc
    v_mov_b32 v4, 262144
    v_cndmask_b32 v63, v4, 0, vcc
    v_add_u32 v13, 0, v13
    v_add_u32 v15, s21, v15
    s_mov_b32 s42, 0x0c0c0400
    s_mov_b32 s43, 0x04000c0c
    s_movk_i32 s40, 0xff00
    s_mov_b32 s48, 0
    s_mov_b32 s49, -1
    s_waitcnt lgkmcnt(0)
    s_add_u32 s24, s24, 2654435769
    s_add_u32 s25, s25, 2135587861
    s_cmp_lg_u32 s30, 0
    s_cbranch_scc1 L_noxt
    s_getreg_b32 s22, hwreg(HW_REG_XCC_ID, 0, 4)
    s_lshl_b32 s21, s19, 8
    s_lshl_b32 s23, s20, 3
    s_add_u32 s21, s21, s23
    s_add_u32 s21, s21, 786432
    s_add_u32 s22, s22, s25
    v_mov_b32 v5, s21
    v_mov_b32 v6, s24
    v_mov_b32 v7, s22
    s_mov_b64 exec, 1
    global_store_dwordx2 v5, v[6:7], s[16:17]
    s_mov_b64 exec, -1
L_noxt:
    s_bfe_u32 s21, s24, 524288
    v_mov_b32 v68, s21
    s_bfe_u32 s21, s24, 524296
    v_mov_b32 v69, s21
    s_bfe_u32 s21, s24, 524304
    v_mov_b32 v70, s21
    s_bfe_u32 s21, s24, 524312
    v_mov_b32 v71, s21
    s_barrier
    buffer_load_dwordx4 v[32:35], v3, s[32:35], 0 offen nt
    buffer_load_dwordx4 v[36:39], v3, s[32:35], 0 offen offset:2048 nt
    buffer_load_dwordx4 v[40:43], v3, s[32:35], s38 offen nt
    s_barrier
    s_barrier
    buffer_load_dwordx4 v[44:47], v3, s[32:35], s38 offen offset:2048 nt
    buffer_load_dwordx4 v[48:51], v3, s[32:35], s39 offen nt
    buffer_load_dwordx4 v[52:55], v3, s[32:35], s39 offen offset:2048 nt
    buffer_load_dwordx4 v[56:59], v14, s[32:35], 0 offen nt
L_wdd:
    s_cmp_eq_u32 s26, 0
    s_cbranch_scc1 L_nols
    s_sleep 20
L_nols:
    s_cmp_lg_u64 s[44:45], 0
    s_cbranch_scc1 L_poll2
    s_sleep 14
    global_load_dwordx4 v[64:67], v12, s[16:17] sc1
L_pl1:
    s_waitcnt vmcnt(0)
    v_and_b32 v4, s40, v64
    v_and_b32 v5, s40, v65
    v_and_b32 v6, s40, v66
    v_and_b32 v7, s40, v67
    v_perm_b32 v1, v65, v64, s42
    v_add_f32_dpp v4, v4, v4 quad_perm:[1,0,3,2] row_mask:0xf bank_mask:0xf
    v_add_f32_dpp v5, v5, v5 quad_perm:[1,0,3,2] row_mask:0xf bank_mask:0xf
    v_add_f32_dpp v6, v6, v6 quad_perm:[1,0,3,2] row_mask:0xf bank_mask:0xf
    v_add_f32_dpp v7, v7, v7 quad_perm:[1,0,3,2] row_mask:0xf bank_mask:0xf
    v_perm_b32 v2, v67, v66, s43
    v_add_f32_dpp v4, v4, v4 quad_perm:[2,3,0,1] row_mask:0xf bank_mask:0xf
    v_add_f32_dpp v5, v5, v5 quad_perm:[2,3,0,1] row_mask:0xf bank_mask:0xf
    v_bitop3_b32 v1, v1, v2, s24 bitop3:0x96
    v_add_f32_dpp v6, v6, v6 quad_perm:[2,3,0,1] row_mask:0xf bank_mask:0xf
    v_add_f32_dpp v7, v7, v7 quad_perm:[2,3,0,1] row_mask:0xf bank_mask:0xf
    v_cvt_pk_bf16_f32 v4, v4, v5
    v_cmp_ne_u32 vcc, 0, v1
    s_add_u32 s41, s41, 1
    v_cvt_pk_bf16_f32 v6, v6, v7
    s_cbranch_vccz L_hok
    global_load_dwordx4 v[64:67], v12, s[16:17] sc1
    s_cmp_lg_u32 s41, 64
    s_cbranch_scc1 L_nsw1
    v_mov_b32 v12, v13
L_nsw1:
    s_cmp_lt_u32 s41, 200000
    s_cbranch_scc1 L_pl1
L_hok:
    v_lshlrev_b32 v5, 16, v4
    v_lshlrev_b32 v7, 16, v6
    v_cmp_lt_f32 vcc, 0, v5
    v_cmp_lt_f32 s[46:47], 0, v7
    v_and_b32 v4, 0xffff0000, v4
    v_and_b32 v6, 0xffff0000, v6
    v_cndmask_b32 v1, 0, 1.0, vcc
    v_cndmask_b32 v2, 0, 1.0, s[46:47]
    v_mul_f32 v5, v5, v1
    v_mul_f32 v7, v7, v2
    v_mul_f32 v5, v5, v4
    v_mul_f32 v7, v7, v6
    v_cvt_pk_bf16_f32 v1, v5, v5
    v_cvt_pk_bf16_f32 v2, v7, v7
    s_nop 0
    v_and_b32_dpp v16, v1, v8 row_newbcast:0 row_mask:0xf bank_mask:0xf
    v_and_b32_dpp v17, v1, v9 row_newbcast:0 row_mask:0xf bank_mask:0xf
    v_and_b32_dpp v18, v1, v10 row_newbcast:0 row_mask:0xf bank_mask:0xf
    v_and_b32_dpp v19, v1, v11 row_newbcast:0 row_mask:0xf bank_mask:0xf
    v_and_b32_dpp v20, v2, v8 row_newbcast:0 row_mask:0xf bank_mask:0xf
    v_and_b32_dpp v21, v2, v9 row_newbcast:0 row_mask:0xf bank_mask:0xf
    v_and_b32_dpp v22, v2, v10 row_newbcast:0 row_mask:0xf bank_mask:0xf
    v_and_b32_dpp v23, v2, v11 row_newbcast:0 row_mask:0xf bank_mask:0xf
    v_cndmask_b32 v3, v1, v2, s[48:49]
    v_mfma_f32_16x16x32_bf16 v[24:27], v[16:19], v[32:35], v[24:27]
    v_and_b32_dpp v104, v1, v8 row_newbcast:4 row_mask:0xf bank_mask:0xf
    v_and_b32_dpp v105, v1, v9 row_newbcast:4 row_mask:0xf bank_mask:0xf
    v_and_b32_dpp v106, v1, v10 row_newbcast:4 row_mask:0xf bank_mask:0xf
    v_and_b32_dpp v107, v1, v11 row_newbcast:4 row_mask:0xf bank_mask:0xf
    v_mfma_f32_16x16x32_bf16 v[28:31], v[20:23], v[36:39], v[28:31]
    v_and_b32_dpp v16, v2, v8 row_newbcast:4 row_mask:0xf bank_mask:0xf
    v_and_b32_dpp v17, v2, v9 row_newbcast:4 row_mask:0xf bank_mask:0xf
    v_and_b32_dpp v18, v2, v10 row_newbcast:4 row_mask:0xf bank_mask:0xf
    v_and_b32_dpp v19, v2, v11 row_newbcast:4 row_mask:0xf bank_mask:0xf
    v_mfma_f32_16x16x32_bf16 v[24:27], v[104:107], v[40:43], v[24:27]
    v_and_b32_dpp v20, v1, v8 row_newbcast:8 row_mask:0xf bank_mask:0xf
    v_and_b32_dpp v21, v1, v9 row_newbcast:8 row_mask:0xf bank_mask:0xf
    v_and_b32_dpp v22, v1, v10 row_newbcast:8 row_mask:0xf bank_mask:0xf
    v_and_b32_dpp v23, v1, v11 row_newbcast:8 row_mask:0xf bank_mask:0xf
    v_mfma_f32_16x16x32_bf16 v[28:31], v[16:19], v[44:47], v[28:31]
    v_and_b32_dpp v104, v2, v8 row_newbcast:8 row_mask:0xf bank_mask:0xf
    v_and_b32_dpp v105, v2, v9 row_newbcast:8 row_mask:0xf bank_mask:0xf
    v_and_b32_dpp v106, v2, v10 row_newbcast:8 row_mask:0xf bank_mask:0xf
    v_and_b32_dpp v107, v2, v11 row_newbcast:8 row_mask:0xf bank_mask:0xf
    v_mfma_f32_16x16x32_bf16 v[24:27], v[20:23], v[48:51], v[24:27]
    v_and_b32_dpp v16, v3, v8 row_newbcast:12 row_mask:0xf bank_mask:0xf
    v_and_b32_dpp v17, v3, v9 row_newbcast:12 row_mask:0xf bank_mask:0xf
    v_and_b32_dpp v18, v3, v10 row_newbcast:12 row_mask:0xf bank_mask:0xf
    v_and_b32_dpp v19, v3, v11 row_newbcast:12 row_mask:0xf bank_mask:0xf
    v_mfma_f32_16x16x32_bf16 v[28:31], v[104:107], v[52:55], v[28:31]
    s_nop 1
    v_mfma_f32_16x16x32_bf16 v[24:27], v[16:19], v[56:59], v[24:27]
    s_nop 7
    v_add_f32 v4, v24, v28
    v_add_f32 v5, v26, v30
    ds_write_b64 v15, v[4:5] offset:2048
    s_waitcnt lgkmcnt(0)
    s_barrier
    s_endpgm
L_poll2:
    s_sleep 14
    global_load_dwordx4 v[64:67], v12, s[16:17] sc1
    s_mov_b64 exec, s[44:45]
    global_load_dwordx4 v[68:71], v12, s[16:17] offset:2048 sc1
    s_mov_b64 exec, -1
L_pl2:
    s_waitcnt vmcnt(0)
    v_and_b32 v4, s40, v64
    v_and_b32 v5, s40, v65
    v_and_b32 v6, s40, v66
    v_and_b32 v7, s40, v67
    v_and_b32 v16, s40, v68
    v_and_b32 v17, s40, v69
    v_and_b32 v18, s40, v70
    v_and_b32 v19, s40, v71
    v_perm_b32 v20, v69, v68, s42
    v_perm_b32 v21, v71, v70, s43
    v_add_f32 v4, v4, v16
    v_add_f32 v5, v5, v17
    v_add_f32 v6, v6, v18
    v_add_f32 v7, v7, v19
    v_bitop3_b32 v20, v20, v21, s24 bitop3:0x96
    v_perm_b32 v1, v65, v64, s42
    v_add_f32_dpp v4, v4, v4 quad_perm:[1,0,3,2] row_mask:0xf bank_mask:0xf
    v_add_f32_dpp v5, v5, v5 quad_perm:[1,0,3,2] row_mask:0xf bank_mask:0xf
    v_add_f32_dpp v6, v6, v6 quad_perm:[1,0,3,2] row_mask:0xf bank_mask:0xf
    v_add_f32_dpp v7, v7, v7 quad_perm:[1,0,3,2] row_mask:0xf bank_mask:0xf
    v_perm_b32 v2, v67, v66, s43
    v_add_f32_dpp v4, v4, v4 quad_perm:[2,3,0,1] row_mask:0xf bank_mask:0xf
    v_add_f32_dpp v5, v5, v5 quad_perm:[2,3,0,1] row_mask:0xf bank_mask:0xf
    v_bitop3_b32 v1, v1, v2, s24 bitop3:0x96
    v_add_f32_dpp v6, v6, v6 quad_perm:[2,3,0,1] row_mask:0xf bank_mask:0xf
    v_add_f32_dpp v7, v7, v7 quad_perm:[2,3,0,1] row_mask:0xf bank_mask:0xf
    v_or_b32 v1, v1, v20
    v_cvt_pk_bf16_f32 v4, v4, v5
    v_cmp_ne_u32 vcc, 0, v1
    s_add_u32 s41, s41, 1
    v_cvt_pk_bf16_f32 v6, v6, v7
    s_cbranch_vccz L_hok
    global_load_dwordx4 v[64:67], v12, s[16:17] sc1
    s_mov_b64 exec, s[44:45]
    global_load_dwordx4 v[68:71], v12, s[16:17] offset:2048 sc1
    s_mov_b64 exec, -1
    s_cmp_lg_u32 s41, 64
    s_cbranch_scc1 L_nsw2
    v_mov_b32 v12, v13
L_nsw2:
    s_cmp_lt_u32 s41, 200000
    s_cbranch_scc1 L_pl2
    s_branch L_hok
L_end:
    s_endpgm
.section .rodata,"a"
.p2align 6
.amdhsa_kernel standalone__glu_gated_reglu__decode_kernel
  .amdhsa_next_free_vgpr 128
  .amdhsa_next_free_sgpr 80
  .amdhsa_accum_offset 128
  .amdhsa_group_segment_fixed_size 0
  .amdhsa_kernarg_size 56
  .amdhsa_user_sgpr_count 2
  .amdhsa_user_sgpr_kernarg_segment_ptr 1
  .amdhsa_system_sgpr_workgroup_id_x 1
  .amdhsa_float_denorm_mode_32 3
.end_amdhsa_kernel
```
